```python
import torch

def _softmax(x, axis=-1):
    return torch.softmax(x, dim=axis)
def _gelu(x):
    return torch.nn.functional.gelu(x, approximate="tanh")
def _silu(x):
    return torch.nn.functional.silu(x)
def _sigmoid(x):
    return torch.sigmoid(x)
def _layernorm(x, axis=-1, eps=1e-5):
    m = x.mean(dim=axis, keepdim=True)
    v = x.var(dim=axis, keepdim=True, unbiased=False)
    return (x - m) / torch.sqrt(v + eps)
def _scatter_add(tgt, idx, src, axis=0):
    return tgt.clone().index_add_(axis, idx, src)
def _segment_sum(src, seg, n):
    out = torch.zeros((n,) + src.shape[1:], dtype=src.dtype)
    return out.index_add_(0, seg, src)
def _pad(x, pw):
    flat = tuple(v for pair in reversed(pw) for v in pair)
    return torch.nn.functional.pad(x, flat)

kernel_name = 'standalone__gqa_softmax__sampling'

def setup_inputs():

    _w = (lambda a: (lambda t: t.to(torch.bfloat16) if t.is_floating_point() else t)(torch.as_tensor(a)))
    B, Hq, Hkv, Sq, Sk, D = 16, 32, 8, 4, 2048, 128
    return {
        "q": _w((lambda *s: torch.randn(*s, dtype=torch.bfloat16) * 0.8)(B, Hq, Sq, D)),
        "k": _w((lambda *s: torch.randn(*s, dtype=torch.bfloat16) * 0.8)(B, Hkv, Sk, D)),
        "v": _w((lambda *s: torch.randn(*s, dtype=torch.bfloat16) * 0.05)(B, Hkv, Sk, D)),
    }

def reference(q, k, v):
    B, Hq, Sq, D = q.shape
    Hkv = k.shape[1]
    rep = Hq // Hkv
    k = (lambda x, n, axis: torch.repeat_interleave(x, n, dim=axis))(k, rep, axis=1)
    v = (lambda x, n, axis: torch.repeat_interleave(x, n, dim=axis))(v, rep, axis=1)
    scale = D ** -0.5
    scores = torch.einsum("bhqd,bhkd->bhqk", q, k) * scale
    p = _softmax(scores, axis=-1)
    return torch.einsum("bhqk,bhkd->bhqd", p, v)
```

```asm
; @launch grid=(256,1,1) block=(320,1,1) lds=158208
.amdgcn_target "amdgcn-amd-amdhsa--gfx950"
.text
.globl standalone__gqa_softmax__sampling_kernel
.p2align 8
.type standalone__gqa_softmax__sampling_kernel,@function
standalone__gqa_softmax__sampling_kernel:
v_readfirstlane_b32 s3, v0
s_lshr_b32 s28, s2, 4
s_and_b32 s29, s2, 7
s_cmp_ge_u32 s3, 64
s_cbranch_scc1 L_cinit
s_load_dwordx8 s[4:11], s[0:1], 0
s_branch L_prod
L_cinit:
s_cmpk_ge_u32 s2, 0x100
s_cbranch_scc1 L_end
v_lshl_add_u32 v127, v0, 2, 0
v_add_u32 v127, 156416, v127
v_and_b32 v2, 0x7f, v0
v_lshlrev_b32 v2, 2, v2
v_add_u32 v2, 157696, v2
v_mov_b32 v1, -4
v_mov_b32 v3, 0
ds_write_b32 v127, v1
ds_write_b32 v2, v3
s_waitcnt lgkmcnt(0)
s_barrier
s_load_dwordx2 s[24:25], s[0:1], 24
s_lshl4_add_u32 s28, s29, s28
s_branch L_cons
L_prod:
s_cmpk_ge_u32 s2, 0x100
s_cbranch_scc1 L_end
s_lshl4_add_u32 s28, s29, s28
v_and_b32 v6, 15, v0
v_lshrrev_b32 v7, 4, v0
v_xor_b32 v8, v6, v7
v_lshlrev_b32 v8, 4, v8
v_lshl_add_u32 v8, v7, 8, v8
v_xor_b32 v9, 64, v8
v_xor_b32 v10, 0x80, v8
v_xor_b32 v11, 0xc0, v8
s_lshl_b32 s29, s28, 19
s_lshl_b32 s28, s28, 12
s_mov_b32 s18, 0x80000
s_mov_b32 s19, 0x20000
s_mov_b32 s14, s18
s_mov_b32 s15, 0x20000
s_brev_b32 s34, s2
s_and_b32 s34, s34, 0x0c000000
s_lshr_b32 s34, s34, 9
s_mov_b32 s35, s34
s_mov_b32 m0, 131072
s_barrier
s_waitcnt lgkmcnt(0)
s_mov_b32 s12, s4
s_mov_b32 s13, s5
buffer_load_dwordx4 v8, s[12:15], s28 offen offset:0 lds
buffer_load_dwordx4 v9, s[12:15], s28 offen offset:1024 lds
buffer_load_dwordx4 v10, s[12:15], s28 offen offset:2048 lds
buffer_load_dwordx4 v11, s[12:15], s28 offen offset:3072 lds
s_mov_b32 m0, 0
s_add_u32 s16, s6, s29
s_addc_u32 s17, s7, 0
L_p0:
buffer_load_dwordx4 v8, s[16:19], s34 offen offset:0 nt lds
buffer_load_dwordx4 v9, s[16:19], s34 offen offset:1024 nt lds
buffer_load_dwordx4 v10, s[16:19], s34 offen offset:2048 nt lds
buffer_load_dwordx4 v11, s[16:19], s34 offen offset:3072 nt lds
s_add_u32 m0, m0, 0x1000
s_addk_i32 s34, 0x1000
s_cmp_lt_u32 m0, 32768
s_cbranch_scc1 L_p0
s_setprio 3
s_add_u32 s20, s8, s29
s_addc_u32 s21, s9, 0
s_mov_b32 s22, 0x80000
s_mov_b32 s23, 0x20000
s_bfe_u32 s30, s2, 0x10003
v_lshrrev_b32 v2, 3, v0
v_and_b32 v3, 6, v2
v_and_b32 v4, 7, v0
v_xor_b32 v4, v4, v3
v_lshlrev_b32 v4, 4, v4
v_lshl_add_u32 v4, v2, 8, v4
s_lshl_b32 s44, s30, 7
v_add_u32 v12, s44, v4
v_add_u32 v13, 0x400, v12
v_add_u32 v14, 0x800, v12
v_add_u32 v15, 0xc00, v12
v_lshlrev_b32 v16, 2, v0
v_add_u32 v16, 157696, v16
v_and_b32 v17, 3, v0
v_lshlrev_b32 v17, 8, v17
v_add_u32 v17, 156672, v17
s_mov_b32 s36, 32768
s_mov_b32 s37, 81920
s_mov_b32 s38, 0
v_mov_b32 v18, -4
.p2align 3
L_ploop:
s_sub_u32 s39, s38, 9
s_and_b32 s50, s39, 3
s_sub_u32 s51, s39, 1
s_and_b32 s51, s51, 3
s_waitcnt lgkmcnt(4)
L_fc:
v_readlane_b32 s46, v18, s50
v_readlane_b32 s47, v18, s51
ds_read_b32 v18, v17
s_nop 1
s_add_u32 s47, s47, 1
s_min_i32 s46, s46, s47
s_cmp_gt_i32 s46, s39
s_cbranch_scc1 L_fd
s_waitcnt lgkmcnt(0)
s_branch L_fc
L_fd:
s_and_b32 s34, s34, 0x7ffff
s_waitcnt vmcnt(32)
s_add_u32 s45, s38, 2
s_cmp_eq_u32 s38, 0
s_cselect_b32 s45, 0, s45
s_cmp_eq_u32 s38, 2
s_cselect_b32 s45, 3, s45
v_mov_b32 v19, s45
ds_write_b32 v16, v19
buffer_load_dwordx4 v8, s[16:19], s34 offen offset:0 nt lds
buffer_load_dwordx4 v9, s[16:19], s34 offen offset:1024 nt lds
buffer_load_dwordx4 v10, s[16:19], s34 offen offset:2048 nt lds
buffer_load_dwordx4 v11, s[16:19], s34 offen offset:3072 nt lds
s_add_u32 m0, m0, 4096
s_add_u32 s44, s34, 4096
s_waitcnt vmcnt(32)
s_add_u32 s45, s38, -3
s_max_i32 s45, s45, 0
v_mov_b32 v20, s45
ds_write_b32 v16, v20 offset:256
buffer_load_dwordx4 v8, s[16:19], s44 offen offset:0 nt lds
buffer_load_dwordx4 v9, s[16:19], s44 offen offset:1024 nt lds
buffer_load_dwordx4 v10, s[16:19], s44 offen offset:2048 nt lds
buffer_load_dwordx4 v11, s[16:19], s44 offen offset:3072 nt lds
s_add_u32 s34, s34, 8192
s_add_u32 s36, s36, 8192
s_cmp_eq_u32 s36, 81920
s_cselect_b32 s36, 0, s36
s_mov_b32 m0, s36
s_and_b32 s34, s34, 0x7ffff
s_waitcnt vmcnt(32)
s_add_u32 s45, s38, -2
s_max_i32 s45, s45, 0
v_mov_b32 v20, s45
ds_write_b32 v16, v20 offset:256
buffer_load_dwordx4 v8, s[16:19], s34 offen offset:0 nt lds
buffer_load_dwordx4 v9, s[16:19], s34 offen offset:1024 nt lds
buffer_load_dwordx4 v10, s[16:19], s34 offen offset:2048 nt lds
buffer_load_dwordx4 v11, s[16:19], s34 offen offset:3072 nt lds
s_add_u32 m0, m0, 4096
s_add_u32 s44, s34, 4096
s_waitcnt vmcnt(32)
buffer_load_dwordx4 v8, s[16:19], s44 offen offset:0 nt lds
buffer_load_dwordx4 v9, s[16:19], s44 offen offset:1024 nt lds
buffer_load_dwordx4 v10, s[16:19], s44 offen offset:2048 nt lds
buffer_load_dwordx4 v11, s[16:19], s44 offen offset:3072 nt lds
s_add_u32 s34, s34, 8192
s_add_u32 s36, s36, 8192
s_cmp_eq_u32 s36, 81920
s_cselect_b32 s36, 0, s36
s_and_b32 s35, s35, 0x7ffff
s_mov_b32 m0, s37
s_add_u32 s37, s37, 4096
s_cmp_eq_u32 s37, 131072
s_cselect_b32 s37, 81920, s37
s_waitcnt vmcnt(32)
s_add_u32 s45, s38, 3
s_cmp_eq_u32 s38, 0
s_cselect_b32 s45, 2, s45
v_mov_b32 v19, s45
ds_write_b32 v16, v19
buffer_load_dwordx4 v12, s[20:23], s35 offen offset:0 nt lds
buffer_load_dwordx4 v13, s[20:23], s35 offen offset:1024 nt lds
buffer_load_dwordx4 v14, s[20:23], s35 offen offset:2048 nt lds
buffer_load_dwordx4 v15, s[20:23], s35 offen offset:3072 nt lds
s_add_u32 s35, s35, 8192
s_and_b32 s35, s35, 0x7ffff
s_mov_b32 m0, s37
s_add_u32 s37, s37, 4096
s_cmp_eq_u32 s37, 131072
s_cselect_b32 s37, 81920, s37
s_waitcnt vmcnt(32)
buffer_load_dwordx4 v12, s[20:23], s35 offen offset:0 nt lds
buffer_load_dwordx4 v13, s[20:23], s35 offen offset:1024 nt lds
buffer_load_dwordx4 v14, s[20:23], s35 offen offset:2048 nt lds
buffer_load_dwordx4 v15, s[20:23], s35 offen offset:3072 nt lds
s_add_u32 s35, s35, 8192
s_mov_b32 m0, s36
s_add_u32 s38, s38, 2
s_cmp_lt_u32 s38, 56
s_cbranch_scc1 L_ploop
L_tc49:
s_waitcnt lgkmcnt(0)
v_readlane_b32 s46, v18, 0
v_readlane_b32 s47, v18, 1
v_readlane_b32 s48, v18, 2
v_readlane_b32 s49, v18, 3
ds_read_b32 v18, v17
s_nop 1
s_min_i32 s46, s46, s47
s_min_i32 s48, s48, s49
s_min_i32 s46, s46, s48
s_cmp_ge_i32 s46, 47
s_cbranch_scc0 L_tc49
s_mov_b32 m0, 0
s_and_b32 s34, s34, 0x7ffff
s_waitcnt vmcnt(32)
v_mov_b32 v19, 58
ds_write_b32 v16, v19
buffer_load_dwordx4 v8, s[16:19], s34 offen offset:0 nt lds
buffer_load_dwordx4 v9, s[16:19], s34 offen offset:1024 nt lds
buffer_load_dwordx4 v10, s[16:19], s34 offen offset:2048 nt lds
buffer_load_dwordx4 v11, s[16:19], s34 offen offset:3072 nt lds
s_add_u32 m0, m0, 4096
s_add_u32 s44, s34, 4096
s_waitcnt vmcnt(32)
v_mov_b32 v20, 53
ds_write_b32 v16, v20 offset:256
buffer_load_dwordx4 v8, s[16:19], s44 offen offset:0 nt lds
buffer_load_dwordx4 v9, s[16:19], s44 offen offset:1024 nt lds
buffer_load_dwordx4 v10, s[16:19], s44 offen offset:2048 nt lds
buffer_load_dwordx4 v11, s[16:19], s44 offen offset:3072 nt lds
s_add_u32 s34, s34, 8192
s_mov_b32 m0, 8192
s_and_b32 s34, s34, 0x7ffff
s_waitcnt vmcnt(32)
v_mov_b32 v20, 54
ds_write_b32 v16, v20 offset:256
buffer_load_dwordx4 v8, s[16:19], s34 offen offset:0 nt lds
buffer_load_dwordx4 v9, s[16:19], s34 offen offset:1024 nt lds
buffer_load_dwordx4 v10, s[16:19], s34 offen offset:2048 nt lds
buffer_load_dwordx4 v11, s[16:19], s34 offen offset:3072 nt lds
s_add_u32 m0, m0, 4096
s_add_u32 s44, s34, 4096
s_waitcnt vmcnt(32)
buffer_load_dwordx4 v8, s[16:19], s44 offen offset:0 nt lds
buffer_load_dwordx4 v9, s[16:19], s44 offen offset:1024 nt lds
buffer_load_dwordx4 v10, s[16:19], s44 offen offset:2048 nt lds
buffer_load_dwordx4 v11, s[16:19], s44 offen offset:3072 nt lds
s_add_u32 s34, s34, 8192
s_mov_b32 m0, 16384
s_and_b32 s34, s34, 0x7ffff
s_waitcnt vmcnt(32)
v_mov_b32 v19, 59
ds_write_b32 v16, v19
buffer_load_dwordx4 v8, s[16:19], s34 offen offset:0 nt lds
buffer_load_dwordx4 v9, s[16:19], s34 offen offset:1024 nt lds
buffer_load_dwordx4 v10, s[16:19], s34 offen offset:2048 nt lds
buffer_load_dwordx4 v11, s[16:19], s34 offen offset:3072 nt lds
s_add_u32 m0, m0, 4096
s_add_u32 s44, s34, 4096
s_waitcnt vmcnt(32)
buffer_load_dwordx4 v8, s[16:19], s44 offen offset:0 nt lds
buffer_load_dwordx4 v9, s[16:19], s44 offen offset:1024 nt lds
buffer_load_dwordx4 v10, s[16:19], s44 offen offset:2048 nt lds
buffer_load_dwordx4 v11, s[16:19], s44 offen offset:3072 nt lds
s_add_u32 s34, s34, 8192
s_mov_b32 m0, 24576
s_and_b32 s34, s34, 0x7ffff
s_waitcnt vmcnt(32)
v_mov_b32 v19, 60
ds_write_b32 v16, v19
buffer_load_dwordx4 v8, s[16:19], s34 offen offset:0 nt lds
buffer_load_dwordx4 v9, s[16:19], s34 offen offset:1024 nt lds
buffer_load_dwordx4 v10, s[16:19], s34 offen offset:2048 nt lds
buffer_load_dwordx4 v11, s[16:19], s34 offen offset:3072 nt lds
s_add_u32 m0, m0, 4096
s_add_u32 s44, s34, 4096
s_waitcnt vmcnt(32)
v_mov_b32 v20, 55
ds_write_b32 v16, v20 offset:256
buffer_load_dwordx4 v8, s[16:19], s44 offen offset:0 nt lds
buffer_load_dwordx4 v9, s[16:19], s44 offen offset:1024 nt lds
buffer_load_dwordx4 v10, s[16:19], s44 offen offset:2048 nt lds
buffer_load_dwordx4 v11, s[16:19], s44 offen offset:3072 nt lds
s_add_u32 s34, s34, 8192
s_and_b32 s35, s35, 0x7ffff
s_mov_b32 m0, 114688
s_waitcnt vmcnt(32)
v_mov_b32 v20, 56
ds_write_b32 v16, v20 offset:256
buffer_load_dwordx4 v12, s[20:23], s35 offen offset:0 nt lds
buffer_load_dwordx4 v13, s[20:23], s35 offen offset:1024 nt lds
buffer_load_dwordx4 v14, s[20:23], s35 offen offset:2048 nt lds
buffer_load_dwordx4 v15, s[20:23], s35 offen offset:3072 nt lds
s_add_u32 s35, s35, 8192
s_and_b32 s35, s35, 0x7ffff
s_mov_b32 m0, 118784
s_waitcnt vmcnt(32)
buffer_load_dwordx4 v12, s[20:23], s35 offen offset:0 nt lds
buffer_load_dwordx4 v13, s[20:23], s35 offen offset:1024 nt lds
buffer_load_dwordx4 v14, s[20:23], s35 offen offset:2048 nt lds
buffer_load_dwordx4 v15, s[20:23], s35 offen offset:3072 nt lds
s_add_u32 s35, s35, 8192
s_and_b32 s35, s35, 0x7ffff
s_mov_b32 m0, 122880
s_waitcnt vmcnt(32)
v_mov_b32 v19, 61
ds_write_b32 v16, v19
buffer_load_dwordx4 v12, s[20:23], s35 offen offset:0 nt lds
buffer_load_dwordx4 v13, s[20:23], s35 offen offset:1024 nt lds
buffer_load_dwordx4 v14, s[20:23], s35 offen offset:2048 nt lds
buffer_load_dwordx4 v15, s[20:23], s35 offen offset:3072 nt lds
s_add_u32 s35, s35, 8192
s_and_b32 s35, s35, 0x7ffff
s_mov_b32 m0, 126976
s_waitcnt vmcnt(32)
buffer_load_dwordx4 v12, s[20:23], s35 offen offset:0 nt lds
buffer_load_dwordx4 v13, s[20:23], s35 offen offset:1024 nt lds
buffer_load_dwordx4 v14, s[20:23], s35 offen offset:2048 nt lds
buffer_load_dwordx4 v15, s[20:23], s35 offen offset:3072 nt lds
s_add_u32 s35, s35, 8192
s_and_b32 s35, s35, 0x7ffff
s_mov_b32 m0, 81920
s_waitcnt vmcnt(32)
v_mov_b32 v19, 62
ds_write_b32 v16, v19
buffer_load_dwordx4 v12, s[20:23], s35 offen offset:0 nt lds
buffer_load_dwordx4 v13, s[20:23], s35 offen offset:1024 nt lds
buffer_load_dwordx4 v14, s[20:23], s35 offen offset:2048 nt lds
buffer_load_dwordx4 v15, s[20:23], s35 offen offset:3072 nt lds
s_add_u32 s35, s35, 8192
ds_read_b32 v18, v17
s_and_b32 s35, s35, 0x7ffff
s_mov_b32 m0, 86016
s_waitcnt vmcnt(32)
buffer_load_dwordx4 v12, s[20:23], s35 offen offset:0 nt lds
buffer_load_dwordx4 v13, s[20:23], s35 offen offset:1024 nt lds
buffer_load_dwordx4 v14, s[20:23], s35 offen offset:2048 nt lds
buffer_load_dwordx4 v15, s[20:23], s35 offen offset:3072 nt lds
s_add_u32 s35, s35, 8192
L_tc51:
s_waitcnt lgkmcnt(0)
v_readlane_b32 s46, v18, 0
v_readlane_b32 s47, v18, 1
v_readlane_b32 s48, v18, 2
v_readlane_b32 s49, v18, 3
ds_read_b32 v18, v17
s_nop 1
s_min_i32 s46, s46, s47
s_min_i32 s48, s48, s49
s_min_i32 s46, s46, s48
s_cmp_ge_i32 s46, 49
s_cbranch_scc0 L_tc51
s_and_b32 s35, s35, 0x7ffff
s_mov_b32 m0, 90112
s_waitcnt vmcnt(32)
v_mov_b32 v19, 63
ds_write_b32 v16, v19
buffer_load_dwordx4 v12, s[20:23], s35 offen offset:0 nt lds
buffer_load_dwordx4 v13, s[20:23], s35 offen offset:1024 nt lds
buffer_load_dwordx4 v14, s[20:23], s35 offen offset:2048 nt lds
buffer_load_dwordx4 v15, s[20:23], s35 offen offset:3072 nt lds
s_add_u32 s35, s35, 8192
s_and_b32 s35, s35, 0x7ffff
s_mov_b32 m0, 94208
s_waitcnt vmcnt(32)
buffer_load_dwordx4 v12, s[20:23], s35 offen offset:0 nt lds
buffer_load_dwordx4 v13, s[20:23], s35 offen offset:1024 nt lds
buffer_load_dwordx4 v14, s[20:23], s35 offen offset:2048 nt lds
buffer_load_dwordx4 v15, s[20:23], s35 offen offset:3072 nt lds
s_add_u32 s35, s35, 8192
s_waitcnt vmcnt(32)
v_mov_b32 v19, 64
ds_write_b32 v16, v19
s_waitcnt vmcnt(16) lgkmcnt(0)
s_barrier
s_waitcnt vmcnt(0)
s_barrier
s_endpgm
L_cons:
s_lshr_b32 s3, s3, 6
s_sub_u32 s3, s3, 1
s_bfe_u32 s30, s2, 0x10003
v_and_b32 v5, 63, v0
v_and_b32 v6, 15, v5
v_lshrrev_b32 v7, 4, v5
s_lshl_b32 s28, s28, 12
s_mov_b32 s26, 0x80000
s_mov_b32 s27, 0x20000
s_mov_b32 s31, 0x3e0293ee
v_xor_b32 v12, v6, v7
v_lshlrev_b32 v12, 4, v12
v_lshl_add_u32 v12, v6, 8, v12
v_xor_b32 v13, 64, v12
v_xor_b32 v14, 0x80, v12
v_xor_b32 v15, 0xc0, v12
s_waitcnt lgkmcnt(0)
v_lshrrev_b32 v2, 2, v5
v_and_b32 v4, 6, v2
v_bfe_u32 v1, v5, 1, 1
v_xor_b32 v4, v4, v1
v_lshlrev_b32 v4, 4, v4
v_lshl_add_u32 v4, v2, 7, v4
v_and_b32 v1, 1, v5
v_lshl_add_u32 v4, v1, 3, v4
s_lshl_b32 s44, s3, 5
v_xor_b32 v4, s44, v4
v_add_u32 v108, 81920, v4
v_xor_b32 v109, 32, v108
v_xor_b32 v110, 64, v108
v_xor_b32 v111, 96, v108
v_lshlrev_b32 v8, 4, v5
s_mul_i32 s44, s3, 0x1400
s_add_u32 s44, s44, 131072
v_add_u32 v122, s44, v8
v_xor_b32 v123, 0x1000, v122
v_xor_b32 v124, 0x2000, v122
v_xor_b32 v125, 0x3000, v122
s_lshl_b32 s44, s3, 11
s_add_u32 s44, s44, 147456
v_add_u32 v9, s44, v8
v_add_u32 v10, 147456, v8
s_lshl_b32 s44, s3, 12
s_add_u32 s44, s44, 131072
v_add_u32 v8, s44, v8
v_lshlrev_b32 v11, 4, v6
v_add_u32 v11, 155648, v11
s_lshl_b32 s44, s3, 8
v_add_u32 v128, s44, v11
v_lshlrev_b32 v126, 8, v6
v_lshl_add_u32 v126, v7, 3, v126
s_lshl_b32 s47, s3, 5
s_lshl_b32 s45, s30, 7
s_add_u32 s47, s47, s45
s_add_u32 s47, s47, s28
v_mov_b32 v4, 157696
v_mov_b64 v[92:93], 0
v_mov_b64 v[94:95], 0
v_mov_b64 v[96:97], 0
v_mov_b64 v[98:99], 0
v_mov_b64 v[100:101], 0
v_mov_b64 v[102:103], 0
v_mov_b64 v[104:105], 0
v_mov_b64 v[106:107], 0
v_mov_b32 v1, 0xff800000
v_mov_b32 v2, 0
s_lshl_b32 s36, s3, 13
s_lshl_b32 s37, s3, 12
s_mov_b32 s38, s3
s_mov_b32 s43, 0
v_mov_b32 v121, 0
v_add_u32 v112, 131072, v12
v_add_u32 v113, 131072, v13
v_add_u32 v114, 131072, v14
v_add_u32 v115, 131072, v15
L_pq0:
ds_read_b32 v3, v4
s_waitcnt lgkmcnt(0)
v_readfirstlane_b32 s42, v3
s_cmp_gt_u32 s42, 0
s_cbranch_scc0 L_pq0
ds_read_b128 v[16:19], v112
ds_read_b128 v[20:23], v113
ds_read_b128 v[24:27], v114
ds_read_b128 v[28:31], v115
.p2align 3
L_cloop:
v_add_u32 v112, s36, v12
v_add_u32 v113, s36, v13
v_add_u32 v114, s36, v14
v_add_u32 v115, s36, v15
s_branch L_pk1
L_pk0:
ds_read_b32 v3, v4
s_waitcnt lgkmcnt(0)
v_readfirstlane_b32 s42, v3
L_pk1:
s_cmp_gt_u32 s42, s38
s_cbranch_scc0 L_pk0
ds_read_b128 v[32:35], v112 offset:0
ds_read_b128 v[36:39], v113 offset:0
ds_read_b128 v[40:43], v114 offset:0
ds_read_b128 v[44:47], v115 offset:0
ds_read_b128 v[48:51], v112 offset:4096
ds_read_b128 v[52:55], v113 offset:4096
ds_read_b128 v[56:59], v114 offset:4096
ds_read_b128 v[60:63], v115 offset:4096
v_mul_f32 v92, v92, v121
v_mul_f32 v93, v93, v121
v_mul_f32 v94, v94, v121
v_mul_f32 v95, v95, v121
v_mul_f32 v96, v96, v121
v_mul_f32 v97, v97, v121
v_mul_f32 v98, v98, v121
v_mul_f32 v99, v99, v121
v_mul_f32 v100, v100, v121
v_mul_f32 v101, v101, v121
v_mul_f32 v102, v102, v121
v_mul_f32 v103, v103, v121
v_mul_f32 v104, v104, v121
v_mul_f32 v105, v105, v121
v_mul_f32 v106, v106, v121
v_mul_f32 v107, v107, v121
v_add_u32 v116, s37, v108
v_add_u32 v117, s37, v109
v_add_u32 v118, s37, v110
v_add_u32 v119, s37, v111
s_add_u32 s36, s36, 32768
s_cmp_ge_u32 s36, 81920
s_cselect_b32 s44, 81920, 0
s_sub_u32 s36, s36, s44
s_waitcnt lgkmcnt(7)
v_mfma_f32_16x16x32_bf16 v[64:67], v[32:35], v[16:19], 0
s_waitcnt lgkmcnt(6)
v_mfma_f32_16x16x32_bf16 v[64:67], v[36:39], v[20:23], v[64:67]
s_waitcnt lgkmcnt(5)
v_mfma_f32_16x16x32_bf16 v[64:67], v[40:43], v[24:27], v[64:67]
s_waitcnt lgkmcnt(4)
v_mfma_f32_16x16x32_bf16 v[64:67], v[44:47], v[28:31], v[64:67]
s_waitcnt lgkmcnt(3)
v_mfma_f32_16x16x32_bf16 v[68:71], v[48:51], v[16:19], 0
s_waitcnt lgkmcnt(2)
v_mfma_f32_16x16x32_bf16 v[68:71], v[52:55], v[20:23], v[68:71]
s_waitcnt lgkmcnt(1)
v_mfma_f32_16x16x32_bf16 v[68:71], v[56:59], v[24:27], v[68:71]
s_waitcnt lgkmcnt(0)
v_mfma_f32_16x16x32_bf16 v[68:71], v[60:63], v[28:31], v[68:71]
v_max3_f32 v3, v64, v65, v66
v_max_f32 v3, v3, v67
v_mul_f32 v64, s31, v64
v_mul_f32 v65, s31, v65
v_mul_f32 v66, s31, v66
v_mul_f32 v67, s31, v67
s_nop 1
v_max3_f32 v3, v3, v68, v69
v_max3_f32 v3, v3, v70, v71
v_mov_b32 v120, v3
v_mul_f32 v68, s31, v68
v_mul_f32 v69, s31, v69
v_permlane16_swap_b32 v3, v120
v_max_f32 v3, v3, v120
v_mov_b32 v120, v3
v_mul_f32 v70, s31, v70
v_mul_f32 v71, s31, v71
v_permlane32_swap_b32 v3, v120
v_max_f32 v3, v3, v120
v_mul_f32 v3, s31, v3
v_max_f32 v3, v3, v1
v_sub_f32 v64, v64, v3
v_sub_f32 v65, v65, v3
v_sub_f32 v66, v66, v3
v_sub_f32 v67, v67, v3
v_sub_f32 v68, v68, v3
v_sub_f32 v69, v69, v3
v_sub_f32 v70, v70, v3
v_sub_f32 v71, v71, v3
v_sub_f32 v121, v1, v3
v_mov_b32 v1, v3
v_exp_f32 v64, v64
v_exp_f32 v65, v65
v_exp_f32 v66, v66
v_exp_f32 v67, v67
v_exp_f32 v68, v68
v_exp_f32 v69, v69
v_exp_f32 v70, v70
v_exp_f32 v71, v71
v_exp_f32 v121, v121
s_cmp_ge_u32 s38, 60
s_cbranch_scc1 L_last
v_mul_f32 v2, v2, v121
v_add_f32 v2, v2, v64
v_add_f32 v2, v2, v65
v_add_f32 v2, v2, v66
v_add_f32 v2, v2, v67
v_add_f32 v2, v2, v68
v_add_f32 v2, v2, v69
v_add_f32 v2, v2, v70
v_add_f32 v2, v2, v71
s_sub_u32 s39, s38, 4
s_cbranch_scc1 L_nopv
s_branch L_pv1
L_pv0:
ds_read_b32 v3, v4 offset:256
s_waitcnt lgkmcnt(0)
v_readfirstlane_b32 s43, v3
L_pv1:
s_cmp_gt_u32 s43, s39
s_cbranch_scc0 L_pv0
ds_read_b64_tr_b16 v[76:77], v116 offset:0
ds_read_b64_tr_b16 v[78:79], v116 offset:2048
ds_read_b64_tr_b16 v[80:81], v117 offset:0
ds_read_b64_tr_b16 v[82:83], v117 offset:2048
ds_read_b64_tr_b16 v[84:85], v118 offset:0
ds_read_b64_tr_b16 v[86:87], v118 offset:2048
ds_read_b64_tr_b16 v[88:89], v119 offset:0
ds_read_b64_tr_b16 v[90:91], v119 offset:2048
s_add_u32 s37, s37, 16384
s_cmp_ge_u32 s37, 49152
s_cselect_b32 s44, 49152, 0
s_sub_u32 s37, s37, s44
s_waitcnt lgkmcnt(6)
v_mfma_f32_16x16x32_bf16 v[92:95], v[76:79], v[72:75], v[92:95]
s_waitcnt lgkmcnt(4)
v_mfma_f32_16x16x32_bf16 v[96:99], v[80:83], v[72:75], v[96:99]
s_waitcnt lgkmcnt(2)
v_mfma_f32_16x16x32_bf16 v[100:103], v[84:87], v[72:75], v[100:103]
s_waitcnt lgkmcnt(0)
v_mfma_f32_16x16x32_bf16 v[104:107], v[88:91], v[72:75], v[104:107]
L_nopv:
s_add_u32 s39, s39, 1
v_mov_b32 v3, s39
ds_write_b32 v127, v3
v_cvt_pk_bf16_f32 v72, v64, v65
v_cvt_pk_bf16_f32 v73, v66, v67
v_cvt_pk_bf16_f32 v74, v68, v69
v_cvt_pk_bf16_f32 v75, v70, v71
s_add_u32 s38, s38, 4
s_cmp_lt_u32 s38, 60
s_cbranch_scc1 L_cloop
ds_write_b128 v9, v[72:75]
ds_write_b32 v128, v1
v_mul_f32 v92, v92, v121
v_mul_f32 v93, v93, v121
v_mul_f32 v94, v94, v121
v_mul_f32 v95, v95, v121
ds_write_b128 v122, v[92:95]
v_mul_f32 v96, v96, v121
v_mul_f32 v97, v97, v121
v_mul_f32 v98, v98, v121
v_mul_f32 v99, v99, v121
ds_write_b128 v123, v[96:99]
v_mul_f32 v100, v100, v121
v_mul_f32 v101, v101, v121
v_mul_f32 v102, v102, v121
v_mul_f32 v103, v103, v121
ds_write_b128 v124, v[100:103]
v_mul_f32 v104, v104, v121
v_mul_f32 v105, v105, v121
v_mul_f32 v106, v106, v121
v_mul_f32 v107, v107, v121
ds_write_b128 v125, v[104:107]
s_branch L_cloop
L_last:
v_cvt_pk_bf16_f32 v72, v64, v65
v_cvt_pk_bf16_f32 v73, v66, v67
v_cvt_pk_bf16_f32 v74, v68, v69
v_cvt_pk_bf16_f32 v75, v70, v71
ds_write_b32 v128, v1 offset:4
ds_write_b128 v9, v[72:75] offset:1024
s_waitcnt lgkmcnt(0)
s_barrier
ds_read_b64 v[136:137], v11 offset:0
ds_read_b64 v[138:139], v11 offset:256
ds_read_b64 v[140:141], v11 offset:512
ds_read_b64 v[142:143], v11 offset:768
ds_read_b128 v[92:95], v8 offset:0
ds_read_b128 v[32:35], v10 offset:0
ds_read_b64_tr_b16 v[76:77], v108 offset:32768
ds_read_b64_tr_b16 v[78:79], v108 offset:34816
ds_read_b128 v[96:99], v8 offset:1024
ds_read_b128 v[36:39], v10 offset:2048
ds_read_b64_tr_b16 v[80:81], v108 offset:36864
ds_read_b64_tr_b16 v[82:83], v108 offset:38912
v_mul_f32 v2, v2, v121
v_add_f32 v64, v64, v65
v_add_f32 v66, v66, v67
v_add_f32 v68, v68, v69
v_add_f32 v70, v70, v71
v_add_f32 v64, v64, v66
v_add_f32 v68, v68, v70
v_add_f32 v2, v2, v64
v_add_f32 v2, v2, v68
s_waitcnt lgkmcnt(8)
ds_read_b128 v[100:103], v8 offset:2048
ds_read_b128 v[40:43], v10 offset:4096
ds_read_b64_tr_b16 v[84:85], v108 offset:40960
ds_read_b64_tr_b16 v[86:87], v108 offset:43008
v_mov_b32 v120, v2
v_max3_f32 v1, v137, v139, v141
v_max_f32 v1, v1, v143
v_permlane16_swap_b32 v2, v120
v_add_f32 v2, v2, v120
s_waitcnt lgkmcnt(8)
v_mfma_f32_16x16x32_bf16 v[92:95], v[76:79], v[32:35], v[92:95]
ds_read_b128 v[104:107], v8 offset:3072
ds_read_b128 v[44:47], v10 offset:6144
ds_read_b64_tr_b16 v[88:89], v108 offset:45056
ds_read_b64_tr_b16 v[90:91], v108 offset:47104
v_mov_b32 v120, v2
v_sub_f32 v136, v136, v1
v_sub_f32 v137, v137, v1
v_sub_f32 v138, v138, v1
v_sub_f32 v139, v139, v1
v_sub_f32 v140, v140, v1
v_sub_f32 v141, v141, v1
v_sub_f32 v142, v142, v1
v_sub_f32 v143, v143, v1
v_permlane32_swap_b32 v2, v120
v_add_f32 v2, v2, v120
s_waitcnt lgkmcnt(8)
v_mfma_f32_16x16x32_bf16 v[96:99], v[80:83], v[36:39], v[96:99]
ds_write_b32 v128, v2 offset:8
v_exp_f32 v136, v136
v_exp_f32 v137, v137
v_exp_f32 v138, v138
v_exp_f32 v139, v139
s_waitcnt lgkmcnt(5)
v_mfma_f32_16x16x32_bf16 v[100:103], v[84:87], v[40:43], v[100:103]
ds_read_b128 v[48:51], v10 offset:1024
ds_read_b128 v[52:55], v10 offset:3072
ds_read_b128 v[56:59], v10 offset:5120
ds_read_b128 v[60:63], v10 offset:7168
v_exp_f32 v140, v140
v_exp_f32 v141, v141
v_exp_f32 v142, v142
v_exp_f32 v143, v143
s_waitcnt lgkmcnt(5)
v_mfma_f32_16x16x32_bf16 v[104:107], v[88:91], v[44:47], v[104:107]
v_mul_f32 v92, v92, v136
v_mul_f32 v93, v93, v136
v_mul_f32 v94, v94, v136
v_mul_f32 v95, v95, v136
v_fmac_f32 v92, v138, v96
v_fmac_f32 v93, v138, v97
v_fmac_f32 v94, v138, v98
v_fmac_f32 v95, v138, v99
v_fmac_f32 v92, v140, v100
v_fmac_f32 v93, v140, v101
v_fmac_f32 v94, v140, v102
v_fmac_f32 v95, v140, v103
v_fmac_f32 v92, v142, v104
v_fmac_f32 v93, v142, v105
v_fmac_f32 v94, v142, v106
v_fmac_f32 v95, v142, v107
s_waitcnt lgkmcnt(0)
s_barrier
ds_read_b64_tr_b16 v[76:77], v108 offset:0
ds_read_b64_tr_b16 v[78:79], v108 offset:2048
ds_read_b32 v144, v11 offset:8
ds_read_b32 v145, v11 offset:264
ds_read_b32 v146, v11 offset:520
ds_read_b32 v147, v11 offset:776
ds_read_b64_tr_b16 v[80:81], v108 offset:4096
ds_read_b64_tr_b16 v[82:83], v108 offset:6144
ds_read_b64_tr_b16 v[84:85], v108 offset:8192
ds_read_b64_tr_b16 v[86:87], v108 offset:10240
ds_read_b64_tr_b16 v[88:89], v108 offset:12288
ds_read_b64_tr_b16 v[90:91], v108 offset:14336
s_waitcnt lgkmcnt(10)
v_mfma_f32_16x16x32_bf16 v[148:151], v[76:79], v[48:51], 0
s_waitcnt lgkmcnt(4)
v_mfma_f32_16x16x32_bf16 v[152:155], v[80:83], v[52:55], 0
v_mul_f32 v2, v137, v144
v_fmac_f32 v2, v139, v145
s_waitcnt lgkmcnt(2)
v_mfma_f32_16x16x32_bf16 v[156:159], v[84:87], v[56:59], 0
v_fmac_f32 v2, v141, v146
v_fmac_f32 v2, v143, v147
s_waitcnt lgkmcnt(0)
v_mfma_f32_16x16x32_bf16 v[160:163], v[88:91], v[60:63], 0
v_rcp_f32 v2, v2
v_fmac_f32 v92, v137, v148
v_fmac_f32 v93, v137, v149
v_fmac_f32 v94, v137, v150
v_fmac_f32 v95, v137, v151
v_fmac_f32 v92, v139, v152
v_fmac_f32 v93, v139, v153
v_fmac_f32 v94, v139, v154
v_fmac_f32 v95, v139, v155
v_fmac_f32 v92, v141, v156
v_fmac_f32 v93, v141, v157
v_fmac_f32 v94, v141, v158
v_fmac_f32 v95, v141, v159
v_fmac_f32 v92, v143, v160
v_fmac_f32 v93, v143, v161
v_fmac_f32 v94, v143, v162
v_fmac_f32 v95, v143, v163
v_mul_f32 v92, v92, v2
v_mul_f32 v93, v93, v2
v_mul_f32 v94, v94, v2
v_mul_f32 v95, v95, v2
v_cvt_pk_bf16_f32 v92, v92, v93
v_cvt_pk_bf16_f32 v93, v94, v95
buffer_store_dwordx2 v[92:93], v126, s[24:27], s47 offen
L_end:
s_endpgm
.section .rodata,"a"
.p2align 6
.amdhsa_kernel standalone__gqa_softmax__sampling_kernel
  .amdhsa_next_free_vgpr 168
  .amdhsa_next_free_sgpr 56
  .amdhsa_accum_offset 168
  .amdhsa_group_segment_fixed_size 0
  .amdhsa_kernarg_size 48
  .amdhsa_user_sgpr_count 2
  .amdhsa_user_sgpr_kernarg_segment_ptr 1
  .amdhsa_system_sgpr_workgroup_id_x 1
.end_amdhsa_kernel
```
